```python
import torch

def _softmax(x, axis=-1):
    return torch.softmax(x, dim=axis)
def _gelu(x):
    return torch.nn.functional.gelu(x, approximate="tanh")
def _silu(x):
    return torch.nn.functional.silu(x)
def _sigmoid(x):
    return torch.sigmoid(x)
def _layernorm(x, axis=-1, eps=1e-5):
    m = x.mean(dim=axis, keepdim=True)
    v = x.var(dim=axis, keepdim=True, unbiased=False)
    return (x - m) / torch.sqrt(v + eps)
def _scatter_add(tgt, idx, src, axis=0):
    return tgt.clone().index_add_(axis, idx, src)
def _segment_sum(src, seg, n):
    out = torch.zeros((n,) + src.shape[1:], dtype=src.dtype)
    return out.index_add_(0, seg, src)
def _pad(x, pw):
    flat = tuple(v for pair in reversed(pw) for v in pair)
    return torch.nn.functional.pad(x, flat)

kernel_name = 'parallel_sum__sliding_block_cached__geglu_ffn__decode'

def setup_inputs():

    _w = (lambda a: (lambda t: t.to(torch.bfloat16) if t.is_floating_point() else t)(torch.as_tensor(a)))
    def _A_setup():
        B, Sq, D = 1, 1, 512
        Hq, Hkv, Sk, Dh = 32, 32, 32768, 128
        assert Hq % Hkv == 0, (Hq, Hkv)
        return {
            "x": _w((lambda *s: torch.randn(*s, dtype=torch.bfloat16) * 0.05)(B, Sq, D)),
            "k_cache": _w((lambda *s: torch.randn(*s, dtype=torch.bfloat16) * 3.2)(B, Hkv, Sk, Dh)),
            "v_cache": _w((lambda *s: torch.randn(*s, dtype=torch.bfloat16) * 1.6)(B, Hkv, Sk, Dh)),
            "wq": _w((lambda *s: torch.randn(*s, dtype=torch.bfloat16) * 3.2)(D, Hq * Dh) * (D ** -0.5)),
            "wo": _w((lambda *s: torch.randn(*s, dtype=torch.bfloat16) * 1.6)(Hq * Dh, D) * ((Hq * Dh) ** -0.5)),
        }
    _A_in = _A_setup()

    def _B_setup():
        B, S, D, F = 1, 1, 512, 1376
        return {
            "x": _w((lambda *s: torch.randn(*s, dtype=torch.bfloat16) * 0.05)(B, S, D)),
            "w_gate": _w((lambda *s: torch.randn(*s, dtype=torch.bfloat16) * 0.05)(D, F)),
            "w_up": _w((lambda *s: torch.randn(*s, dtype=torch.bfloat16) * 0.05)(D, F)),
            "w_down": _w((lambda *s: torch.randn(*s, dtype=torch.bfloat16) * 0.05)(F, D)),
        }
    _B_in = _B_setup()

    return {
        "A_x": _A_in["x"],
        "A_k_cache": _A_in["k_cache"],
        "A_v_cache": _A_in["v_cache"],
        "A_wq": _A_in["wq"],
        "A_wo": _A_in["wo"],
        "B_x": _B_in["x"],
        "B_w_gate": _B_in["w_gate"],
        "B_w_up": _B_in["w_up"],
        "B_w_down": _B_in["w_down"],
    }

def reference(A_x, A_k_cache, A_v_cache, A_wq, A_wo, B_x, B_w_gate, B_w_up, B_w_down):
    def _A_ref(x, k_cache, v_cache, wq, wo):
        B, Sq, D = x.shape
        Hq, Dh = 32, 128
        Hkv, Sk = k_cache.shape[1], k_cache.shape[2]
        W = min(4096, max(256, Sk // 4))
        rep = Hq // Hkv
        q = (lambda x, *d: x.permute(*d))((x @ wq).reshape(B, Sq, Hq, Dh), 0, 2, 1, 3)
        k = (lambda x, n, axis: torch.repeat_interleave(x, n, dim=axis))(k_cache[:, :, Sk - W:, :], rep, axis=1)
        v = (lambda x, n, axis: torch.repeat_interleave(x, n, dim=axis))(v_cache[:, :, Sk - W:, :], rep, axis=1)
        scores = torch.einsum("bhqd,bhkd->bhqk", q, k) * (Dh ** -0.5)
        p = _softmax(scores, axis=-1)
        o = torch.einsum("bhqk,bhkd->bhqd", p, v)
        return (lambda x, *d: x.permute(*d))(o, 0, 2, 1, 3).reshape(B, Sq, Hq * Dh) @ wo

    def _B_ref(x, w_gate, w_up, w_down):
        return (_gelu(x @ w_gate) * (x @ w_up)) @ w_down

    x = A_x
    xn = _layernorm(x, axis=-1)
    return x + _A_ref(xn, A_k_cache, A_v_cache, A_wq, A_wo) + _B_ref(xn, B_w_gate, B_w_up, B_w_down)
```

```asm
; @launch grid=(256,1,1) block=(512,1,1) lds=18432
.amdgcn_target "amdgcn-amd-amdhsa--gfx950"
.text
.globl parallel_sum__sliding_block_cached__geglu_ffn__decode_kernel
.p2align 8
.type parallel_sum__sliding_block_cached__geglu_ffn__decode_kernel,@function
parallel_sum__sliding_block_cached__geglu_ffn__decode_kernel:
    s_cmp_ge_u32 s2, 256
    s_cbranch_scc1 L_end
    s_load_dwordx16 s[8:23], s[0:1], 0
    s_load_dwordx8 s[24:31], s[0:1], 64
    s_getpc_b64 s[90:91]
L_pc:
    s_and_b32 s3, s2, 0x38
    s_cbranch_scc1 L_nocpf
    v_lshlrev_b32 v10, 4, v0
    v_min_u32 v10, L_codeend - L_pc - 16, v10
    global_load_dwordx4 v[56:59], v10, s[90:91]
L_nocpf:
    s_setprio 3
    v_and_b32 v1, 63, v0
    s_lshr_b32 s3, s2, 3
    s_and_b32 s4, s2, 7
    v_bfe_u32 v13, v0, 3, 1
    v_and_b32 v14, 7, v0
    s_and_b32 s6, s2, 3
    s_lshl_b32 s6, s6, 7
    v_lshrrev_b32 v15, 4, v0
    v_lshl_add_u32 v15, v15, 2, s6
    v_lshl_add_u32 v21, v13, 1, v15
    v_xor_b32 v23, 2, v21
    v_lshlrev_b32 v16, 4, v1
    v_lshlrev_b32 v17, 1, v21
    s_andn2_b32 s43, s2, 3
    s_lshl_b32 s43, s43, 5
    v_lshl_add_u32 v19, v14, 4, s43
    v_lshl_add_u32 v19, v21, 13, v19
    v_add_u32 v20, 0x2000, v19
    s_lshl_b32 s44, s3, 6
    s_lshl_b32 s45, s3, 5
    s_addk_i32 s45, 352
    s_cmp_lt_u32 s3, 11
    s_cselect_b32 s44, s44, s45
    s_cselect_b32 s47, 7, 3
    s_lshl_b32 s46, s44, 1
    v_min_u32 v22, s47, v14
    v_lshl_add_u32 v22, v22, 4, s46
    s_movk_i32 s48, 2752
    v_mad_u32_u24 v22, v23, s48, v22
    s_bitcmp0_b32 s2, 2
    s_waitcnt lgkmcnt(0)
    global_load_dwordx4 v[192:195], v16, s[8:9]
    global_load_dword v196, v17, s[8:9]
    s_cselect_b64 s[20:21], s[20:21], s[22:23]
    global_load_dwordx4 v[200:203], v19, s[14:15] nt
    global_load_dwordx4 v[204:207], v20, s[14:15] nt
    global_load_dwordx4 v[208:211], v22, s[20:21] nt
    global_load_dwordx4 v[212:215], v22, s[20:21] offset:2752 nt
    v_mov_b32 v24, 0
    v_mov_b32 v25, 0
    v_mov_b32 v26, 0
    ds_write_b96 v24, v[24:26] offset:9216
    s_lshl_b32 s49, s3, 23
    s_mul_i32 s50, s4, 32768
    s_add_u32 s49, s49, s50
    s_add_u32 s49, s49, 7340032
    v_lshl_add_u32 v32, v0, 4, s49
    v_add_u32 v33, 0x2000, v32
    v_add_u32 v34, 0x4000, v32
    v_add_u32 v35, 0x6000, v32
    s_waitcnt lgkmcnt(0)
    s_barrier
    global_load_dwordx4 v[64:67], v32, s[10:11] nt
    s_setprio 2
    global_load_dwordx4 v[68:71], v33, s[10:11] nt
    s_setprio 1
    global_load_dwordx4 v[72:75], v34, s[10:11] nt
    s_setprio 0
    global_load_dwordx4 v[76:79], v35, s[10:11] nt
    s_load_dword s32, s[30:31], 0
    v_lshrrev_b32 v10, 6, v0
    v_lshrrev_b32 v11, 4, v1
    v_readfirstlane_b32 s5, v10
    v_add_u32 v36, 0x40000, v32
    v_add_u32 v37, 0x42000, v32
    v_add_u32 v38, 0x44000, v32
    v_add_u32 v39, 0x46000, v32
    v_add_u32 v40, 0x80000, v32
    v_add_u32 v41, 0x82000, v32
    v_add_u32 v42, 0x84000, v32
    v_add_u32 v43, 0x86000, v32
    v_add_u32 v44, 0xc0000, v32
    v_add_u32 v45, 0xc2000, v32
    v_add_u32 v46, 0xc4000, v32
    v_add_u32 v47, 0xc6000, v32
    s_lshl_b32 s7, s5, 4
    s_lshl3_add_u32 s93, s47, 7
    s_mov_b32 s36, 0xcccccccc
    s_mov_b32 s37, 0xcccccccc
    s_mov_b32 s38, 0xaaaaaaaa
    s_mov_b32 s39, 0xaaaaaaaa
    s_mov_b32 s40, 0x00ff00ff
    s_mov_b32 s41, 0xff00ff00
    s_mov_b32 s52, -1
    s_mov_b32 s53, 0
    s_mov_b32 s54, 0x01010101
    s_mov_b32 s55, 0x01010101
    v_and_b32 v24, 1, v1
    v_lshlrev_b32 v24, 4, v24
    v_mov_b32 v25, 0xffff
    v_lshlrev_b32 v24, v24, v25
    s_mov_b32 s56, 0x3030303
    s_mov_b32 s57, 0x3030303
    v_cndmask_b32 v2, 0, v24, s[56:57]
    s_mov_b32 s56, 0xc0c0c0c
    s_mov_b32 s57, 0xc0c0c0c
    v_cndmask_b32 v3, 0, v24, s[56:57]
    s_mov_b32 s56, 0x30303030
    s_mov_b32 s57, 0x30303030
    v_cndmask_b32 v4, 0, v24, s[56:57]
    s_mov_b32 s56, 0xc0c0c0c0
    s_mov_b32 s57, 0xc0c0c0c0
    v_cndmask_b32 v5, 0, v24, s[56:57]
    s_lshl_b32 s57, s4, 7
    s_lshl2_add_u32 s42, s3, s57
    v_and_b32 v24, 1, v11
    v_lshlrev_b32 v24, 3, v24
    v_lshl_add_u32 v24, v13, 2, v24
    v_lshrrev_b32 v25, 1, v11
    v_add_u32 v24, v24, v25
    s_lshl_b32 s56, s3, 7
    s_add_u32 s56, s56, s7
    v_add_u32 v24, s56, v24
    v_lshl_add_u32 v25, v14, 4, s57
    v_lshl_add_u32 v248, v24, 10, v25
    v_lshl_add_u32 v24, v11, 1, v13
    s_lshl_b32 s56, s5, 3
    v_add_u32 v254, s56, v24
    v_min_u32 v24, s93, v254
    v_add_u32 v26, s44, v24
    v_lshl_add_u32 v249, v26, 10, v25
    v_lshlrev_b32 v31, 2, v24
    s_lshl_b32 s56, s3, 13
    s_add_u32 s96, s56, 0x40000
    s_add_u32 s97, s56, 0x100000
    s_lshl_b32 s56, s3, 10
    s_add_u32 s98, s56, 0x180000
    s_lshl_b32 s56, s4, 14
    s_add_u32 s99, s56, 0x1a0000
    v_lshrrev_b32 v24, 3, v1
    s_lshl_b32 s57, s5, 7
    v_lshlrev_b32 v25, 10, v24
    v_lshl_add_u32 v25, v14, 4, v25
    v_add_u32 v25, s57, v25
    v_lshlrev_b32 v26, 9, v24
    v_lshl_add_u32 v26, v14, 4, v26
    s_lshr_b32 s56, s47, 1
    s_add_u32 s56, s56, 4
    s_min_u32 s56, s56, s5
    s_lshl_b32 s56, s56, 6
    s_lshl_b32 s96, s3, 12
    s_add_u32 s96, s96, 0x40000
    s_add_u32 s56, s56, s96
    v_add_u32 v252, s56, v26
    s_mov_b32 s100, 0x0f0f0f0f
    s_mov_b32 s101, 0x0f0f0f0f
    v_add_u32 v250, s97, v25
    v_lshl_add_u32 v251, v1, 4, s98
    v_lshrrev_b32 v24, 1, v11
    s_lshl_b32 s56, s5, 10
    v_lshl_add_u32 v25, v24, 9, s56
    v_and_b32 v26, 1, v11
    v_lshl_add_u32 v25, v26, 4, v25
    v_lshl_add_u32 v30, v14, 5, v25
    v_xor_b32 v26, v24, v13
    v_lshl_add_u32 v30, v26, 8, v30
    v_and_b32 v24, 1, v11
    v_lshl_add_u32 v24, v13, 1, v24
    v_lshl_add_u32 v24, v14, 2, v24
    v_lshrrev_b32 v25, 5, v1
    v_lshl_add_u32 v24, v25, 6, v24
    s_lshr_b32 s56, s5, 2
    s_lshl_b32 s56, s56, 6
    s_add_u32 s56, s56, s7
    v_add_lshl_u32 v29, v24, s56, 2
    s_waitcnt vmcnt(8)
    v_lshlrev_b32 v10, 16, v192
    v_and_b32 v11, 0xffff0000, v192
    v_lshlrev_b32 v12, 16, v193
    v_and_b32 v13, 0xffff0000, v193
    v_lshlrev_b32 v14, 16, v194
    v_and_b32 v15, 0xffff0000, v194
    v_lshlrev_b32 v16, 16, v195
    v_and_b32 v17, 0xffff0000, v195
    v_readfirstlane_b32 s56, v10
    s_nop 1
    v_subrev_f32 v10, s56, v10
    v_subrev_f32 v11, s56, v11
    v_subrev_f32 v12, s56, v12
    v_subrev_f32 v13, s56, v13
    v_subrev_f32 v14, s56, v14
    v_subrev_f32 v15, s56, v15
    v_subrev_f32 v16, s56, v16
    v_subrev_f32 v17, s56, v17
    v_add_f32 v18, v10, v11
    v_mul_f32 v19, v10, v10
    v_add_f32 v20, v12, v13
    v_mul_f32 v21, v11, v11
    v_fmac_f32 v19, v12, v12
    v_fmac_f32 v21, v13, v13
    v_add_f32 v18, v18, v14
    v_add_f32 v20, v20, v15
    v_fmac_f32 v19, v14, v14
    v_fmac_f32 v21, v15, v15
    v_add_f32 v18, v18, v16
    v_add_f32 v20, v20, v17
    v_fmac_f32 v19, v16, v16
    v_fmac_f32 v21, v17, v17
    v_add_f32 v18, v18, v20
    v_add_f32 v19, v19, v21
    s_nop 0
    v_add_f32_dpp v18, v18, v18 quad_perm:[1,0,3,2] row_mask:0xf bank_mask:0xf
    v_add_f32_dpp v19, v19, v19 quad_perm:[1,0,3,2] row_mask:0xf bank_mask:0xf
    s_nop 0
    v_add_f32_dpp v18, v18, v18 quad_perm:[2,3,0,1] row_mask:0xf bank_mask:0xf
    v_add_f32_dpp v19, v19, v19 quad_perm:[2,3,0,1] row_mask:0xf bank_mask:0xf
    s_nop 0
    v_add_f32_dpp v18, v18, v18 row_half_mirror row_mask:0xf bank_mask:0xf
    v_add_f32_dpp v19, v19, v19 row_half_mirror row_mask:0xf bank_mask:0xf
    s_nop 0
    v_add_f32_dpp v18, v18, v18 row_mirror row_mask:0xf bank_mask:0xf
    v_add_f32_dpp v19, v19, v19 row_mirror row_mask:0xf bank_mask:0xf
    v_mov_b32 v20, v18
    v_mov_b32 v21, v19
    s_nop 0
    v_permlane16_swap_b32 v20, v18
    v_permlane16_swap_b32 v21, v19
    v_add_f32 v18, v20, v18
    v_add_f32 v19, v21, v19
    v_mov_b32 v20, v18
    v_mov_b32 v21, v19
    s_nop 0
    v_permlane32_swap_b32 v20, v18
    v_permlane32_swap_b32 v21, v19
    v_add_f32 v18, v20, v18
    v_add_f32 v19, v21, v19
    v_mul_f32 v18, 0x3b000000, v18
    v_mul_f32 v19, 0x3b000000, v19
    v_fma_f32 v19, -v18, v18, v19
    v_add_f32 v18, s56, v18
    v_max_f32 v19, 0, v19
    v_cvt_pk_bf16_f32 v20, v18, v19
    v_lshlrev_b32 v18, 16, v20
    v_and_b32 v19, 0xffff0000, v20
    v_add_f32 v19, 0x3727c5ac, v19
    v_cvt_pk_bf16_f32 v19, v19, v19
    v_lshlrev_b32 v19, 16, v19
    v_sqrt_f32 v19, v19
    v_lshlrev_b32 v21, 16, v196
    v_and_b32 v22, 0xffff0000, v196
    v_cvt_pk_bf16_f32 v19, v19, v19
    v_lshlrev_b32 v19, 16, v19
    v_rcp_f32 v20, v19
    v_sub_f32 v21, v21, v18
    v_sub_f32 v22, v22, v18
    v_cvt_pk_bf16_f32 v21, v21, v22
    v_and_b32 v22, 0xffff0000, v21
    v_lshlrev_b32 v21, 16, v21
    v_mul_f32 v10, v21, v20
    v_mul_f32 v11, v22, v20
    v_fma_f32 v12, -v10, v19, v21
    v_fma_f32 v13, -v11, v19, v22
    v_fmac_f32 v10, v12, v20
    v_fmac_f32 v11, v13, v20
    v_cvt_pk_bf16_f32 v10, v10, v10
    v_cvt_pk_bf16_f32 v11, v11, v11
    v_and_b32 v20, v10, v2
    v_and_b32 v21, v10, v3
    v_and_b32 v22, v10, v4
    v_and_b32 v23, v10, v5
    v_and_b32 v24, v11, v2
    v_and_b32 v25, v11, v3
    v_and_b32 v26, v11, v4
    v_and_b32 v27, v11, v5
    s_waitcnt vmcnt(4)
    v_mfma_f32_16x16x32_bf16 v[48:51], v[20:23], v[200:203], 0
    v_mfma_f32_16x16x32_bf16 v[52:55], v[20:23], v[208:211], 0
    v_mfma_f32_16x16x32_bf16 v[48:51], v[24:27], v[204:207], v[48:51]
    v_mfma_f32_16x16x32_bf16 v[52:55], v[24:27], v[212:215], v[52:55]
    global_load_dwordx4 v[80:83], v36, s[10:11] nt
    s_nop 6
    v_cndmask_b32 v48, v52, v48, s[40:41]
    v_cndmask_b32 v49, v53, v49, s[40:41]
    v_cndmask_b32 v50, v54, v50, s[40:41]
    v_cndmask_b32 v51, v55, v51, s[40:41]
    ds_write_b128 v30, v[48:51] offset:0
    v_mov_b32 v28, 0
    v_mov_b32 v27, 1
    s_mov_b64 exec, 1
    ds_add_rtn_u32 v10, v28, v27 offset:9216
    s_mov_b64 exec, -1
    s_waitcnt lgkmcnt(0)
    v_readfirstlane_b32 s56, v10
    s_add_u32 s33, s32, 0x9e3779b9
    s_xor_b32 s34, s33, 0x5bd1e995
    s_cmp_lg_u32 s56, 7
    s_cbranch_scc1 L_nopub0
    global_load_dwordx4 v[84:87], v37, s[10:11] nt
    global_load_dwordx4 v[88:91], v38, s[10:11] nt
    v_lshlrev_b32 v10, 3, v1
    ds_read_b64 v[192:193], v10 offset:0
    ds_read_b64 v[194:195], v10 offset:512
    ds_read_b64 v[196:197], v10 offset:1024
    ds_read_b64 v[198:199], v10 offset:1536
    ds_read_b64 v[200:201], v10 offset:2048
    ds_read_b64 v[202:203], v10 offset:2560
    ds_read_b64 v[204:205], v10 offset:3072
    ds_read_b64 v[206:207], v10 offset:3584
    ds_read_b64 v[208:209], v10 offset:4096
    ds_read_b64 v[210:211], v10 offset:4608
    ds_read_b64 v[212:213], v10 offset:5120
    ds_read_b64 v[214:215], v10 offset:5632
    ds_read_b64 v[216:217], v10 offset:6144
    ds_read_b64 v[218:219], v10 offset:6656
    ds_read_b64 v[220:221], v10 offset:7168
    ds_read_b64 v[222:223], v10 offset:7680
    s_lshl_b32 s56, s4, 9
    s_add_u32 s56, s56, s96
    v_lshl_add_u32 v11, v1, 3, s56
    v_mov_b32 v19, s33
    s_mov_b32 s56, 0x07060503
    s_mov_b32 s57, 0x07060502
    s_mov_b32 s59, 0x07060501
    s_waitcnt lgkmcnt(0)
    v_add_f32 v192, v192, v208
    v_add_f32 v193, v193, v209
    v_add_f32 v194, v194, v210
    v_add_f32 v195, v195, v211
    v_add_f32 v196, v196, v212
    v_add_f32 v197, v197, v213
    v_add_f32 v198, v198, v214
    v_add_f32 v199, v199, v215
    v_add_f32 v200, v200, v216
    v_add_f32 v201, v201, v217
    v_add_f32 v202, v202, v218
    v_add_f32 v203, v203, v219
    v_add_f32 v204, v204, v220
    v_add_f32 v205, v205, v221
    v_add_f32 v206, v206, v222
    v_add_f32 v207, v207, v223
    v_add_f32 v192, v192, v200
    v_add_f32 v193, v193, v201
    v_add_f32 v194, v194, v202
    v_add_f32 v195, v195, v203
    v_add_f32 v196, v196, v204
    v_add_f32 v197, v197, v205
    v_add_f32 v198, v198, v206
    v_add_f32 v199, v199, v207
    v_add_f32 v192, v192, v196
    v_add_f32 v193, v193, v197
    v_add_f32 v194, v194, v198
    v_add_f32 v195, v195, v199
    v_add_f32 v12, v192, v194
    v_add_f32 v14, v193, v195
    v_add_u32 v12, 0x80, v12
    v_add_u32 v14, 0x80, v14
    s_nop 0
    v_mov_b32_dpp v13, v12 quad_perm:[1,0,3,2] row_mask:0xf bank_mask:0xf
    v_mov_b32_dpp v15, v14 quad_perm:[1,0,3,2] row_mask:0xf bank_mask:0xf
    v_perm_b32 v16, v12, v15, s56
    v_perm_b32 v17, v14, v15, s57
    v_perm_b32 v18, v13, v15, s59
    s_andn2_b64 exec, exec, s[38:39]
    global_store_dwordx4 v11, v[16:19], s[30:31] sc1
    s_mov_b64 exec, -1
    s_branch L_join0
L_nopub0:
    s_waitcnt vmcnt(4)
    global_load_dwordx4 v[84:87], v37, s[10:11] nt
    s_waitcnt vmcnt(4)
    global_load_dwordx4 v[88:91], v38, s[10:11] nt
L_join0:
    s_waitcnt vmcnt(4)
    global_load_dwordx4 v[92:95], v39, s[10:11] nt
    s_waitcnt vmcnt(4)
    global_load_dwordx4 v[96:99], v40, s[10:11] nt
    s_waitcnt vmcnt(4)
    global_load_dwordx4 v[100:103], v41, s[10:11] nt
    s_waitcnt vmcnt(4)
    global_load_dwordx4 v[104:107], v42, s[10:11] nt
    s_waitcnt vmcnt(4)
    global_load_dwordx4 v[108:111], v43, s[10:11] nt
    s_waitcnt vmcnt(4)
    s_mov_b64 exec, s[100:101]
    global_load_dwordx4 v[216:219], v252, s[30:31] sc1
    s_mov_b64 exec, -1
    s_waitcnt vmcnt(4)
    global_load_dwordx4 v[112:115], v44, s[10:11] nt
    s_waitcnt vmcnt(4)
    global_load_dwordx4 v[116:119], v45, s[10:11] nt
    s_waitcnt vmcnt(4)
    global_load_dwordx4 v[120:123], v46, s[10:11] nt
    s_waitcnt vmcnt(4)
    global_load_dwordx4 v[124:127], v47, s[10:11] nt
    s_mov_b32 s58, 262144
    s_waitcnt vmcnt(4)
    s_mov_b64 exec, s[100:101]
L_chk0:
    v_cmp_ne_u32 vcc, s33, v219
    s_and_b64 vcc, vcc, exec
    s_cbranch_scc0 L_ok0
    s_sub_u32 s58, s58, 1
    s_cbranch_scc1 L_ok0
    global_load_dwordx4 v[216:219], v252, s[30:31] sc1
    s_waitcnt vmcnt(0)
    s_branch L_chk0
L_ok0:
    s_mov_b64 exec, -1
    s_mov_b32 s56, 0x04000c0c
    s_mov_b32 s57, 0x0706000c
    v_perm_b32 v219, v216, v217, s56
    v_and_b32 v216, 0xffffff00, v216
    v_and_b32 v217, 0xffffff00, v217
    v_perm_b32 v219, v219, v218, s57
    v_and_b32 v218, 0xffffff00, v218
    v_permlane16_swap_b32 v216, v217
    v_add_f32 v10, v216, v217
    v_permlane16_swap_b32 v218, v219
    v_add_f32 v11, v218, v219
    v_and_b32 v12, 15, v1
    v_add_f32_dpp v10, v10, v10 row_ror:8 row_mask:0xf bank_mask:0x3
    v_add_f32_dpp v10, v11, v11 row_ror:8 row_mask:0xf bank_mask:0xc
    v_lshlrev_b32 v12, 5, v12
    s_mov_b64 exec, s[100:101]
    ds_write_b32 v29, v10 offset:8192
    s_mov_b64 exec, 1
    ds_add_u32 v28, v27 offset:9220
    s_mov_b64 exec, -1
    global_load_dwordx4 v[128:131], v32, s[12:13] nt
    s_waitcnt vmcnt(4)
    global_load_dwordx4 v[132:135], v33, s[12:13] nt
    s_waitcnt vmcnt(4)
    global_load_dwordx4 v[136:139], v34, s[12:13] nt
    s_mov_b32 s58, 4194304
L_qwait:
    ds_read_b32 v11, v28 offset:9220
    ds_read_b128 v[16:19], v12 offset:8192
    ds_read_b128 v[20:23], v12 offset:8208
    ds_read_b32 v24, v31 offset:8704
    ds_read_b32 v25, v31 offset:8960
    s_waitcnt lgkmcnt(0)
    v_readfirstlane_b32 s56, v11
    s_cmp_eq_u32 s56, 8
    s_cbranch_scc1 L_qok
    s_sub_u32 s58, s58, 1
    s_cbranch_scc0 L_qwait
L_qok:
    v_cvt_pk_bf16_f32 v6, v16, v17
    v_cvt_pk_bf16_f32 v7, v18, v19
    v_cvt_pk_bf16_f32 v8, v20, v21
    v_cvt_pk_bf16_f32 v9, v22, v23
    v_dot2_f32_bf16 v48, v64, v6, 0
    v_dot2_f32_bf16 v49, v68, v6, 0
    v_dot2_f32_bf16 v50, v72, v6, 0
    v_dot2_f32_bf16 v51, v76, v6, 0
    v_dot2_f32_bf16 v48, v65, v7, v48
    v_dot2_f32_bf16 v49, v69, v7, v49
    v_dot2_f32_bf16 v50, v73, v7, v50
    v_dot2_f32_bf16 v51, v77, v7, v51
    v_dot2_f32_bf16 v48, v66, v8, v48
    v_dot2_f32_bf16 v49, v70, v8, v49
    v_dot2_f32_bf16 v50, v74, v8, v50
    v_dot2_f32_bf16 v51, v78, v8, v51
    v_dot2_f32_bf16 v48, v67, v9, v48
    v_dot2_f32_bf16 v49, v71, v9, v49
    v_dot2_f32_bf16 v50, v75, v9, v50
    v_dot2_f32_bf16 v51, v79, v9, v51
    v_dot2_f32_bf16 v52, v80, v6, 0
    v_dot2_f32_bf16 v53, v84, v6, 0
    v_dot2_f32_bf16 v54, v88, v6, 0
    v_dot2_f32_bf16 v55, v92, v6, 0
    v_dot2_f32_bf16 v52, v81, v7, v52
    v_dot2_f32_bf16 v53, v85, v7, v53
    v_dot2_f32_bf16 v54, v89, v7, v54
    v_dot2_f32_bf16 v55, v93, v7, v55
    v_dot2_f32_bf16 v52, v82, v8, v52
    v_dot2_f32_bf16 v53, v86, v8, v53
    v_dot2_f32_bf16 v54, v90, v8, v54
    v_dot2_f32_bf16 v55, v94, v8, v55
    v_dot2_f32_bf16 v52, v83, v9, v52
    v_dot2_f32_bf16 v53, v87, v9, v53
    s_waitcnt vmcnt(4)
    global_load_dwordx4 v[140:143], v35, s[12:13] nt
    v_dot2_f32_bf16 v54, v91, v9, v54
    v_dot2_f32_bf16 v55, v95, v9, v55
    v_dot2_f32_bf16 v56, v96, v6, 0
    v_dot2_f32_bf16 v57, v100, v6, 0
    v_dot2_f32_bf16 v58, v104, v6, 0
    v_dot2_f32_bf16 v59, v108, v6, 0
    v_dot2_f32_bf16 v56, v97, v7, v56
    v_dot2_f32_bf16 v57, v101, v7, v57
    v_dot2_f32_bf16 v58, v105, v7, v58
    v_dot2_f32_bf16 v59, v109, v7, v59
    v_dot2_f32_bf16 v56, v98, v8, v56
    v_dot2_f32_bf16 v57, v102, v8, v57
    v_dot2_f32_bf16 v58, v106, v8, v58
    v_dot2_f32_bf16 v59, v110, v8, v59
    v_dot2_f32_bf16 v56, v99, v9, v56
    v_dot2_f32_bf16 v57, v103, v9, v57
    v_dot2_f32_bf16 v58, v107, v9, v58
    v_dot2_f32_bf16 v59, v111, v9, v59
    s_waitcnt vmcnt(4)
    v_dot2_f32_bf16 v60, v112, v6, 0
    v_dot2_f32_bf16 v61, v116, v6, 0
    v_dot2_f32_bf16 v62, v120, v6, 0
    v_dot2_f32_bf16 v63, v124, v6, 0
    v_dot2_f32_bf16 v60, v113, v7, v60
    v_dot2_f32_bf16 v61, v117, v7, v61
    v_dot2_f32_bf16 v62, v121, v7, v62
    v_dot2_f32_bf16 v63, v125, v7, v63
    v_dot2_f32_bf16 v60, v114, v8, v60
    v_dot2_f32_bf16 v61, v118, v8, v61
    v_dot2_f32_bf16 v62, v122, v8, v62
    v_dot2_f32_bf16 v63, v126, v8, v63
    global_load_dwordx4 v[144:147], v36, s[12:13] nt
    v_dot2_f32_bf16 v60, v115, v9, v60
    v_dot2_f32_bf16 v61, v119, v9, v61
    v_dot2_f32_bf16 v62, v123, v9, v62
    v_dot2_f32_bf16 v63, v127, v9, v63
    v_cvt_pk_bf16_f32 v24, v24, v25
    v_lshlrev_b32 v26, 16, v24
    v_and_b32 v25, 0xffff0000, v24
    v_mul_f32 v27, v26, v26
    v_mul_f32 v27, v27, v26
    v_mov_b32 v28, v26
    v_fmac_f32 v28, 0x3d372713, v27
    v_mul_f32 v28, 0xc0135761, v28
    v_exp_f32 v28, v28
    v_add_f32_dpp v48, v48, v48 row_ror:8 row_mask:0xf bank_mask:0x3
    v_add_f32_dpp v48, v56, v56 row_ror:8 row_mask:0xf bank_mask:0xc
    v_add_f32_dpp v49, v49, v49 row_ror:8 row_mask:0xf bank_mask:0x3
    v_add_f32_dpp v49, v57, v57 row_ror:8 row_mask:0xf bank_mask:0xc
    v_add_f32_dpp v50, v50, v50 row_ror:8 row_mask:0xf bank_mask:0x3
    v_add_f32_dpp v50, v58, v58 row_ror:8 row_mask:0xf bank_mask:0xc
    v_add_f32_dpp v51, v51, v51 row_ror:8 row_mask:0xf bank_mask:0x3
    v_add_f32_dpp v51, v59, v59 row_ror:8 row_mask:0xf bank_mask:0xc
    v_add_f32_dpp v52, v52, v52 row_ror:8 row_mask:0xf bank_mask:0x3
    v_add_f32_dpp v52, v60, v60 row_ror:8 row_mask:0xf bank_mask:0xc
    v_add_f32_dpp v53, v53, v53 row_ror:8 row_mask:0xf bank_mask:0x3
    v_add_f32_dpp v53, v61, v61 row_ror:8 row_mask:0xf bank_mask:0xc
    v_add_f32_dpp v54, v54, v54 row_ror:8 row_mask:0xf bank_mask:0x3
    v_add_f32_dpp v54, v62, v62 row_ror:8 row_mask:0xf bank_mask:0xc
    v_add_f32_dpp v55, v55, v55 row_ror:8 row_mask:0xf bank_mask:0x3
    v_add_f32_dpp v55, v63, v63 row_ror:8 row_mask:0xf bank_mask:0xc
    v_add_f32 v28, 1.0, v28
    v_rcp_f32 v28, v28
    v_add_f32_dpp v48, v48, v48 row_half_mirror row_mask:0xf bank_mask:0x5
    v_add_f32_dpp v48, v52, v52 row_half_mirror row_mask:0xf bank_mask:0xa
    v_add_f32_dpp v49, v49, v49 row_half_mirror row_mask:0xf bank_mask:0x5
    v_add_f32_dpp v49, v53, v53 row_half_mirror row_mask:0xf bank_mask:0xa
    v_add_f32_dpp v50, v50, v50 row_half_mirror row_mask:0xf bank_mask:0x5
    v_add_f32_dpp v50, v54, v54 row_half_mirror row_mask:0xf bank_mask:0xa
    v_add_f32_dpp v51, v51, v51 row_half_mirror row_mask:0xf bank_mask:0x5
    v_add_f32_dpp v51, v55, v55 row_half_mirror row_mask:0xf bank_mask:0xa
    v_mul_f32 v28, v26, v28
    v_cvt_pk_bf16_f32 v28, v28, v28
    v_add_f32_dpp v48, v48, v48 quad_perm:[2,3,0,1] row_mask:0xf bank_mask:0xf
    v_add_f32_dpp v49, v49, v49 quad_perm:[2,3,0,1] row_mask:0xf bank_mask:0xf
    v_add_f32_dpp v50, v50, v50 quad_perm:[2,3,0,1] row_mask:0xf bank_mask:0xf
    v_add_f32_dpp v51, v51, v51 quad_perm:[2,3,0,1] row_mask:0xf bank_mask:0xf
    v_lshlrev_b32 v28, 16, v28
    v_cndmask_b32 v48, v48, v50, s[36:37]
    v_cndmask_b32 v49, v49, v51, s[36:37]
    v_mul_f32 v28, v28, v25
    v_cmp_ge_u32 vcc, s93, v254
    v_add_f32_dpp v48, v48, v48 quad_perm:[1,0,3,2] row_mask:0xf bank_mask:0xf
    v_add_f32_dpp v49, v49, v49 quad_perm:[1,0,3,2] row_mask:0xf bank_mask:0xf
    v_cndmask_b32 v28, 0, v28, vcc
    v_cndmask_b32 v10, v48, v49, s[38:39]
    v_cvt_pk_bf16_f32 v28, v28, v28
    v_cvt_pk_bf16_f32 v10, v10, v10
    v_and_b32 v236, v28, v2
    v_and_b32 v237, v28, v3
    v_and_b32 v238, v28, v4
    v_and_b32 v239, v28, v5
    v_lshlrev_b32 v10, 16, v10
    v_mul_f32 v10, 0x3db504f3, v10
    v_cvt_pk_bf16_f32 v10, v10, v10
    v_lshlrev_b32 v10, 16, v10
    s_waitcnt vmcnt(4)
    global_load_dwordx4 v[148:151], v37, s[12:13] nt
    v_mov_b32 v14, v10
    s_lshl_b32 s56, s4, 7
    s_lshl_b32 s57, s5, 4
    v_max_f32_dpp v14, v14, v14 quad_perm:[1,0,3,2] row_mask:0xf bank_mask:0xf
    s_nop 1
    v_max_f32_dpp v14, v14, v14 quad_perm:[2,3,0,1] row_mask:0xf bank_mask:0xf
    s_nop 1
    v_max_f32_dpp v14, v14, v14 row_half_mirror row_mask:0xf bank_mask:0xf
    s_nop 1
    v_max_f32_dpp v14, v14, v14 row_mirror row_mask:0xf bank_mask:0xf
    v_mov_b32 v12, v14
    s_nop 1
    v_permlane16_swap_b32 v12, v14
    v_max_f32 v14, v12, v14
    v_mov_b32 v12, v14
    s_nop 1
    v_permlane32_swap_b32 v12, v14
    v_max_f32 v14, v12, v14
    s_add_u32 s56, s56, s57
    s_add_u32 s56, s56, s98
    v_mov_b32 v11, s56
    v_mov_b32 v13, s33
    v_mov_b32 v15, s34
    s_lshl_b32 s56, s5, 2
    v_mov_b32 v17, s56
    v_mov_b32 v30, 1
    v_mov_b32 v31, 0
    v_sub_f32 v10, v10, v14
    v_mul_f32 v10, 0x3fb8aa3b, v10
    v_exp_f32 v10, v10
    s_nop 0
    v_mov_b32 v12, v10
    v_cvt_pk_bf16_f32 v10, v10, v10
    s_nop 0
    v_add_f32_dpp v12, v12, v12 quad_perm:[1,0,3,2] row_mask:0xf bank_mask:0xf
    v_and_b32_dpp v64, v10, v2 row_newbcast:0 row_mask:0xf bank_mask:0xf
    v_and_b32_dpp v65, v10, v3 row_newbcast:0 row_mask:0xf bank_mask:0xf
    v_and_b32_dpp v66, v10, v4 row_newbcast:0 row_mask:0xf bank_mask:0xf
    v_and_b32_dpp v67, v10, v5 row_newbcast:0 row_mask:0xf bank_mask:0xf
    v_add_f32_dpp v12, v12, v12 quad_perm:[2,3,0,1] row_mask:0xf bank_mask:0xf
    v_and_b32_dpp v68, v10, v2 row_newbcast:1 row_mask:0xf bank_mask:0xf
    v_and_b32_dpp v69, v10, v3 row_newbcast:1 row_mask:0xf bank_mask:0xf
    v_and_b32_dpp v70, v10, v4 row_newbcast:1 row_mask:0xf bank_mask:0xf
    v_and_b32_dpp v71, v10, v5 row_newbcast:1 row_mask:0xf bank_mask:0xf
    v_add_f32_dpp v12, v12, v12 row_half_mirror row_mask:0xf bank_mask:0xf
    v_and_b32_dpp v72, v10, v2 row_newbcast:2 row_mask:0xf bank_mask:0xf
    v_and_b32_dpp v73, v10, v3 row_newbcast:2 row_mask:0xf bank_mask:0xf
    v_and_b32_dpp v74, v10, v4 row_newbcast:2 row_mask:0xf bank_mask:0xf
    v_and_b32_dpp v75, v10, v5 row_newbcast:2 row_mask:0xf bank_mask:0xf
    v_add_f32_dpp v12, v12, v12 row_mirror row_mask:0xf bank_mask:0xf
    v_and_b32_dpp v76, v10, v2 row_newbcast:3 row_mask:0xf bank_mask:0xf
    v_and_b32_dpp v77, v10, v3 row_newbcast:3 row_mask:0xf bank_mask:0xf
    v_and_b32_dpp v78, v10, v4 row_newbcast:3 row_mask:0xf bank_mask:0xf
    v_and_b32_dpp v79, v10, v5 row_newbcast:3 row_mask:0xf bank_mask:0xf
    v_mov_b32 v16, v12
    v_and_b32_dpp v80, v10, v2 row_newbcast:4 row_mask:0xf bank_mask:0xf
    v_and_b32_dpp v81, v10, v3 row_newbcast:4 row_mask:0xf bank_mask:0xf
    v_and_b32_dpp v82, v10, v4 row_newbcast:4 row_mask:0xf bank_mask:0xf
    v_and_b32_dpp v83, v10, v5 row_newbcast:4 row_mask:0xf bank_mask:0xf
    v_permlane16_swap_b32 v16, v12
    v_add_f32 v12, v16, v12
    v_mov_b32 v16, v12
    v_and_b32_dpp v84, v10, v2 row_newbcast:5 row_mask:0xf bank_mask:0xf
    v_and_b32_dpp v85, v10, v3 row_newbcast:5 row_mask:0xf bank_mask:0xf
    s_waitcnt vmcnt(4)
    global_load_dwordx4 v[152:155], v38, s[12:13] nt
    v_and_b32_dpp v86, v10, v4 row_newbcast:5 row_mask:0xf bank_mask:0xf
    v_and_b32_dpp v87, v10, v5 row_newbcast:5 row_mask:0xf bank_mask:0xf
    v_permlane32_swap_b32 v16, v12
    v_add_f32 v12, v16, v12
    v_and_b32_dpp v88, v10, v2 row_newbcast:6 row_mask:0xf bank_mask:0xf
    v_and_b32_dpp v89, v10, v3 row_newbcast:6 row_mask:0xf bank_mask:0xf
    v_and_b32_dpp v90, v10, v4 row_newbcast:6 row_mask:0xf bank_mask:0xf
    v_and_b32_dpp v91, v10, v5 row_newbcast:6 row_mask:0xf bank_mask:0xf
    s_mov_b64 exec, 1
    global_store_dwordx4 v11, v[12:15], s[30:31] sc1
    ds_write_b32 v17, v14 offset:9248
    ds_add_u32 v31, v30 offset:9224
    s_mov_b64 exec, -1
    v_and_b32_dpp v92, v10, v2 row_newbcast:7 row_mask:0xf bank_mask:0xf
    v_and_b32_dpp v93, v10, v3 row_newbcast:7 row_mask:0xf bank_mask:0xf
    v_and_b32_dpp v94, v10, v4 row_newbcast:7 row_mask:0xf bank_mask:0xf
    v_and_b32_dpp v95, v10, v5 row_newbcast:7 row_mask:0xf bank_mask:0xf
    v_and_b32_dpp v96, v10, v2 row_newbcast:8 row_mask:0xf bank_mask:0xf
    v_and_b32_dpp v97, v10, v3 row_newbcast:8 row_mask:0xf bank_mask:0xf
    v_and_b32_dpp v98, v10, v4 row_newbcast:8 row_mask:0xf bank_mask:0xf
    v_and_b32_dpp v99, v10, v5 row_newbcast:8 row_mask:0xf bank_mask:0xf
    v_and_b32_dpp v100, v10, v2 row_newbcast:9 row_mask:0xf bank_mask:0xf
    v_and_b32_dpp v101, v10, v3 row_newbcast:9 row_mask:0xf bank_mask:0xf
    v_and_b32_dpp v102, v10, v4 row_newbcast:9 row_mask:0xf bank_mask:0xf
    v_and_b32_dpp v103, v10, v5 row_newbcast:9 row_mask:0xf bank_mask:0xf
    v_and_b32_dpp v104, v10, v2 row_newbcast:10 row_mask:0xf bank_mask:0xf
    v_and_b32_dpp v105, v10, v3 row_newbcast:10 row_mask:0xf bank_mask:0xf
    v_and_b32_dpp v106, v10, v4 row_newbcast:10 row_mask:0xf bank_mask:0xf
    v_and_b32_dpp v107, v10, v5 row_newbcast:10 row_mask:0xf bank_mask:0xf
    v_and_b32_dpp v108, v10, v2 row_newbcast:11 row_mask:0xf bank_mask:0xf
    v_and_b32_dpp v109, v10, v3 row_newbcast:11 row_mask:0xf bank_mask:0xf
    v_and_b32_dpp v110, v10, v4 row_newbcast:11 row_mask:0xf bank_mask:0xf
    v_and_b32_dpp v111, v10, v5 row_newbcast:11 row_mask:0xf bank_mask:0xf
    v_and_b32_dpp v112, v10, v2 row_newbcast:12 row_mask:0xf bank_mask:0xf
    v_and_b32_dpp v113, v10, v3 row_newbcast:12 row_mask:0xf bank_mask:0xf
    v_and_b32_dpp v114, v10, v4 row_newbcast:12 row_mask:0xf bank_mask:0xf
    v_and_b32_dpp v115, v10, v5 row_newbcast:12 row_mask:0xf bank_mask:0xf
    v_and_b32_dpp v116, v10, v2 row_newbcast:13 row_mask:0xf bank_mask:0xf
    v_and_b32_dpp v117, v10, v3 row_newbcast:13 row_mask:0xf bank_mask:0xf
    v_and_b32_dpp v118, v10, v4 row_newbcast:13 row_mask:0xf bank_mask:0xf
    v_and_b32_dpp v119, v10, v5 row_newbcast:13 row_mask:0xf bank_mask:0xf
    v_and_b32_dpp v120, v10, v2 row_newbcast:14 row_mask:0xf bank_mask:0xf
    v_and_b32_dpp v121, v10, v3 row_newbcast:14 row_mask:0xf bank_mask:0xf
    v_and_b32_dpp v122, v10, v4 row_newbcast:14 row_mask:0xf bank_mask:0xf
    v_and_b32_dpp v123, v10, v5 row_newbcast:14 row_mask:0xf bank_mask:0xf
    v_and_b32_dpp v124, v10, v2 row_newbcast:15 row_mask:0xf bank_mask:0xf
    v_and_b32_dpp v125, v10, v3 row_newbcast:15 row_mask:0xf bank_mask:0xf
    v_and_b32_dpp v126, v10, v4 row_newbcast:15 row_mask:0xf bank_mask:0xf
    v_and_b32_dpp v127, v10, v5 row_newbcast:15 row_mask:0xf bank_mask:0xf
    v_lshrrev_b32 v16, 4, v1
    v_and_b32 v17, 15, v1
    s_mul_i32 s56, s5, 544
    v_lshl_add_u32 v18, v17, 5, s56
    v_lshl_add_u32 v18, v16, 4, v18
    v_mul_u32_u24 v29, 288, v17
    s_lshl_b32 s56, s3, 3
    v_add_u32 v29, s56, v29
    v_and_b32 v17, 7, v1
    v_lshrrev_b32 v19, 3, v1
    s_lshl_b32 s56, s5, 6
    v_lshl_add_u32 v20, v19, 3, s56
    v_mov_b32 v21, 544
    v_mad_u32_u24 v21, v17, v21, v20
    v_mov_b32 v22, 288
    v_mad_u32_u24 v22, v17, v22, v20
    s_lshl_b32 s56, s4, 10
    s_lshl_b32 s57, s5, 7
    s_add_u32 s56, s56, s57
    s_add_u32 s56, s56, s97
    v_lshl_add_u32 v23, v19, 4, s56
    s_lshl_b32 s56, s3, 9
    s_add_u32 s56, s56, s57
    s_add_u32 s56, s56, s99
    v_lshl_add_u32 v24, v19, 4, s56
    v_xor_b32 v19, 0x60000, v24
    v_lshrrev_b32 v25, 1, v16
    v_mul_u32_u24 v25, 288, v25
    s_waitcnt vmcnt(4)
    global_load_dwordx4 v[156:159], v39, s[12:13] nt
    s_mul_i32 s56, s5, 576
    v_add_u32 v25, s56, v25
    v_and_b32 v26, 1, v16
    v_lshl_add_u32 v25, v26, 4, v25
    v_lshl_add_u32 v25, v17, 5, v25
    v_and_b32 v26, 31, v1
    s_lshl4_add_u32 s56, s3, s99
    v_lshl_add_u32 v26, v26, 9, s56
    v_xor_b32 v20, 0x60000, v26
    v_mov_b32 v27, s42
    v_lshlrev_b32 v28, 5, v17
    s_lshl_b32 s56, s4, 3
    s_lshl_b64 s[60:61], 0xff, s56
    s_not_b64 s[62:63], s[60:61]
    s_lshl_b64 s[46:47], 1, s3
    s_andn2_b64 s[50:51], s[52:53], s[46:47]
    v_mfma_f32_16x16x32_bf16 v[240:243], v[64:67], v[128:131], 0
    v_mfma_f32_16x16x32_bf16 v[240:243], v[68:71], v[132:135], v[240:243]
    v_mfma_f32_16x16x32_bf16 v[240:243], v[72:75], v[136:139], v[240:243]
    v_mfma_f32_16x16x32_bf16 v[240:243], v[76:79], v[140:143], v[240:243]
    s_waitcnt vmcnt(4)
    v_mfma_f32_16x16x32_bf16 v[240:243], v[80:83], v[144:147], v[240:243]
    global_load_dwordx4 v[160:163], v40, s[12:13] nt
    s_waitcnt vmcnt(4)
    v_mfma_f32_16x16x32_bf16 v[240:243], v[84:87], v[148:151], v[240:243]
    global_load_dwordx4 v[164:167], v41, s[12:13] nt
    s_cmp_lg_u32 s5, 4
    s_cbranch_scc1 L_nopre2
    s_mov_b64 exec, s[50:51]
    global_load_dwordx4 v[60:63], v20, s[30:31] sc1
    s_mov_b64 exec, -1
L_nopre2:
    s_waitcnt vmcnt(4)
    v_mfma_f32_16x16x32_bf16 v[240:243], v[88:91], v[152:155], v[240:243]
    global_load_dwordx4 v[168:171], v42, s[12:13] nt
    global_load_dwordx4 v[172:175], v43, s[12:13] nt
    s_waitcnt vmcnt(4)
    v_mfma_f32_16x16x32_bf16 v[240:243], v[92:95], v[156:159], v[240:243]
    global_load_dwordx4 v[216:219], v251, s[30:31] sc1
    s_waitcnt vmcnt(4)
    v_mfma_f32_16x16x32_bf16 v[240:243], v[96:99], v[160:163], v[240:243]
    global_load_dwordx4 v[176:179], v44, s[12:13] nt
    s_waitcnt vmcnt(4)
    v_mfma_f32_16x16x32_bf16 v[240:243], v[100:103], v[164:167], v[240:243]
    global_load_dwordx4 v[180:183], v45, s[12:13] nt
    s_waitcnt vmcnt(4)
    v_mfma_f32_16x16x32_bf16 v[240:243], v[104:107], v[168:171], v[240:243]
    global_load_dwordx4 v[184:187], v46, s[12:13] nt
    s_waitcnt vmcnt(4)
    v_mfma_f32_16x16x32_bf16 v[240:243], v[108:111], v[172:175], v[240:243]
    global_load_dwordx4 v[188:191], v47, s[12:13] nt
    global_load_dword v197, v27, s[8:9]
    s_mov_b32 s58, 4194304
L_mxwait:
    ds_read_b32 v16, v31 offset:9224
    ds_read_b128 v[48:51], v31 offset:9248
    ds_read_b128 v[52:55], v31 offset:9264
    s_waitcnt lgkmcnt(0)
    v_readfirstlane_b32 s56, v16
    s_cmp_eq_u32 s56, 8
    s_cbranch_scc1 L_mxok
    s_sub_u32 s58, s58, 1
    s_cbranch_scc0 L_mxwait
L_mxok:
    v_max3_f32 v48, v48, v49, v50
    v_max3_f32 v51, v51, v52, v53
    v_max3_f32 v48, v48, v54, v55
    v_max_f32 v48, v48, v51
    v_sub_f32 v10, v14, v48
    v_mul_f32 v10, 0x3fb8aa3b, v10
    v_exp_f32 v30, v10
    s_mov_b32 s58, 262144
    s_waitcnt vmcnt(5)
L_chk1:
    v_cmp_ne_u32 vcc, s33, v217
    v_cmp_ne_u32 s[56:57], s34, v219
    s_or_b64 vcc, vcc, s[56:57]
    s_cbranch_scc0 L_ok1
    s_sub_u32 s58, s58, 1
    s_cbranch_scc1 L_ok1
    s_sleep 4
    global_load_dwordx4 v[216:219], v251, s[30:31] sc1
    s_waitcnt vmcnt(0)
    s_branch L_chk1
L_ok1:
    v_max_f32_dpp v16, v218, v218 quad_perm:[1,0,3,2] row_mask:0xf bank_mask:0xf
    s_nop 1
    v_max_f32_dpp v16, v16, v16 quad_perm:[2,3,0,1] row_mask:0xf bank_mask:0xf
    s_nop 1
    v_max_f32_dpp v16, v16, v16 row_half_mirror row_mask:0xf bank_mask:0xf
    s_nop 1
    v_max_f32_dpp v10, v16, v16 row_ror:8 row_mask:0xf bank_mask:0xf
    v_mov_b32 v11, v10
    s_nop 1
    v_permlane16_swap_b32 v11, v10
    v_max_f32 v10, v11, v10
    v_mov_b32 v11, v10
    s_nop 1
    v_permlane32_swap_b32 v11, v10
    v_max_f32 v10, v11, v10
    v_sub_f32 v11, v218, v10
    v_sub_f32 v10, v16, v10
    v_mul_f32 v11, 0x3fb8aa3b, v11
    v_mul_f32 v10, 0x3fb8aa3b, v10
    v_exp_f32 v11, v11
    v_exp_f32 v10, v10
    v_mul_f32 v11, v11, v216
    s_nop 1
    v_add_f32_dpp v11, v11, v11 quad_perm:[1,0,3,2] row_mask:0xf bank_mask:0xf
    s_nop 1
    v_add_f32_dpp v11, v11, v11 quad_perm:[2,3,0,1] row_mask:0xf bank_mask:0xf
    s_nop 1
    v_add_f32_dpp v11, v11, v11 row_half_mirror row_mask:0xf bank_mask:0xf
    s_nop 1
    v_add_f32_dpp v11, v11, v11 row_mirror row_mask:0xf bank_mask:0xf
    v_mov_b32 v16, v11
    s_nop 1
    v_permlane16_swap_b32 v16, v11
    v_add_f32 v11, v16, v11
    v_mov_b32 v16, v11
    s_nop 1
    v_permlane32_swap_b32 v16, v11
    v_add_f32 v11, v16, v11
    v_rcp_f32 v11, v11
    s_nop 0
    v_mul_f32 v253, v10, v11
    s_waitcnt vmcnt(4)
    v_mfma_f32_16x16x32_bf16 v[240:243], v[112:115], v[176:179], v[240:243]
    s_waitcnt vmcnt(3)
    v_mfma_f32_16x16x32_bf16 v[240:243], v[116:119], v[180:183], v[240:243]
    s_waitcnt vmcnt(2)
    v_mfma_f32_16x16x32_bf16 v[240:243], v[120:123], v[184:187], v[240:243]
    s_waitcnt vmcnt(1)
    v_mfma_f32_16x16x32_bf16 v[240:243], v[124:127], v[188:191], v[240:243]
    global_load_dwordx4 v[232:235], v249, s[24:25] nt
    global_load_dwordx4 v[224:227], v248, s[16:17] nt
    global_load_dwordx4 v[228:231], v248, s[16:17] offset:2048 nt
    s_mov_b64 exec, s[52:53]
    s_mov_b32 s58, 262144
    s_nop 2
    v_mul_f32 v240, v30, v240
    v_mul_f32 v241, v30, v241
    v_mul_f32 v242, v30, v242
    v_mul_f32 v243, v30, v243
    ds_write_b128 v18, v[240:243] offset:9472
    s_mov_b64 exec, -1
    s_waitcnt lgkmcnt(0)
    s_barrier
    ds_read_b64 v[16:17], v21 offset:9472
    s_waitcnt lgkmcnt(0)
    v_add_f32_dpp v14, v17, v17 quad_perm:[1,0,3,2] row_mask:0xf bank_mask:0xf
    v_add_f32_dpp v12, v16, v16 quad_perm:[1,0,3,2] row_mask:0xf bank_mask:0xf
    s_nop 0
    v_add_f32_dpp v14, v14, v14 quad_perm:[2,3,0,1] row_mask:0xf bank_mask:0xf
    v_add_f32_dpp v12, v12, v12 quad_perm:[2,3,0,1] row_mask:0xf bank_mask:0xf
    s_nop 0
    v_add_f32_dpp v14, v14, v14 row_half_mirror row_mask:0xf bank_mask:0xf
    v_add_f32_dpp v12, v12, v12 row_half_mirror row_mask:0xf bank_mask:0xf
    s_mov_b64 exec, s[54:55]
    global_store_dwordx4 v23, v[12:15], s[30:31] sc1
    s_mov_b64 exec, s[62:63]
    global_load_dwordx4 v[64:67], v250, s[30:31] sc1
    s_mov_b64 exec, -1
    ds_bpermute_b32 v10, v28, v12
    ds_bpermute_b32 v11, v28, v14
    s_waitcnt vmcnt(4)
    v_mfma_f32_16x16x32_bf16 v[244:247], v[236:239], v[232:235], 0
    s_mov_b64 exec, s[60:61]
    s_waitcnt lgkmcnt(0)
    v_mul_f32 v220, v253, v10
    v_mul_f32 v222, v253, v11
    s_mov_b64 exec, s[62:63]
    s_branch L_skipO
L_pollO:
    global_load_dwordx4 v[64:67], v250, s[30:31] sc1
L_skipO:
    s_waitcnt vmcnt(0)
    v_cmp_eq_u32 vcc, s33, v65
    v_cmp_eq_u32 s[56:57], s34, v67
    s_and_b64 exec, vcc, s[56:57]
    v_mul_f32 v220, v253, v64
    v_mul_f32 v222, v253, v66
    s_andn2_b64 s[62:63], s[62:63], exec
    s_cbranch_scc0 L_doneO
    s_mov_b64 exec, s[62:63]
    s_sleep 2
    s_sub_u32 s58, s58, 1
    s_cbranch_scc0 L_pollO
L_doneO:
    s_mov_b64 exec, -1
    v_permlane32_swap_b32 v220, v222
    v_add_f32 v10, v220, v222
    v_mov_b32 v11, v10
    s_nop 1
    v_permlane16_swap_b32 v11, v10
    v_add_f32 v10, v11, v10
    s_nop 1
    v_add_f32_dpp v10, v10, v10 row_ror:8 row_mask:0xf bank_mask:0xf
    v_cvt_pk_bf16_f32 v10, v10, v10
    s_nop 1
    v_mov_b32_dpp v16, v10 row_newbcast:0 row_mask:0x5 bank_mask:0x3
    v_mov_b32_dpp v16, v10 row_newbcast:2 row_mask:0x5 bank_mask:0xc
    v_mov_b32_dpp v16, v10 row_newbcast:4 row_mask:0xa bank_mask:0x3
    v_mov_b32_dpp v16, v10 row_newbcast:6 row_mask:0xa bank_mask:0xc
    v_mov_b32_dpp v17, v10 row_newbcast:1 row_mask:0x5 bank_mask:0x3
    v_mov_b32_dpp v17, v10 row_newbcast:3 row_mask:0x5 bank_mask:0xc
    v_mov_b32_dpp v17, v10 row_newbcast:5 row_mask:0xa bank_mask:0x3
    v_mov_b32_dpp v17, v10 row_newbcast:7 row_mask:0xa bank_mask:0xc
    v_and_b32 v48, v16, v2
    v_and_b32 v49, v16, v3
    v_and_b32 v50, v16, v4
    v_and_b32 v51, v16, v5
    v_and_b32 v52, v17, v2
    v_and_b32 v53, v17, v3
    v_mfma_f32_16x16x32_bf16 v[244:247], v[48:51], v[224:227], v[244:247]
    v_and_b32 v54, v17, v4
    v_and_b32 v55, v17, v5
    s_cmp_ge_u32 s5, 4
    s_nop 0
    v_mfma_f32_16x16x32_bf16 v[244:247], v[52:55], v[228:231], v[244:247]
    s_mov_b64 exec, s[40:41]
    s_nop 6
    ds_write_b128 v25, v[244:247] offset:13824
    s_mov_b64 exec, -1
    s_waitcnt lgkmcnt(0)
    s_barrier
    s_cbranch_scc1 L_final
    ds_read_b64 v[16:17], v22 offset:13824
    ds_read_b64 v[30:31], v22 offset:16128
    s_waitcnt lgkmcnt(0)
    v_add_f32 v14, v17, v31
    v_add_f32 v12, v16, v30
    s_nop 0
    v_add_f32_dpp v14, v14, v14 quad_perm:[1,0,3,2] row_mask:0xf bank_mask:0xf
    v_add_f32_dpp v12, v12, v12 quad_perm:[1,0,3,2] row_mask:0xf bank_mask:0xf
    s_nop 0
    v_add_f32_dpp v14, v14, v14 quad_perm:[2,3,0,1] row_mask:0xf bank_mask:0xf
    v_add_f32_dpp v12, v12, v12 quad_perm:[2,3,0,1] row_mask:0xf bank_mask:0xf
    s_nop 0
    v_add_f32_dpp v14, v14, v14 row_half_mirror row_mask:0xf bank_mask:0xf
    v_add_f32_dpp v12, v12, v12 row_half_mirror row_mask:0xf bank_mask:0xf
    s_mov_b64 exec, s[54:55]
    global_store_dwordx4 v19, v[12:15], s[30:31]
    global_store_dwordx4 v24, v[12:15], s[30:31] sc1
    s_endpgm
L_final:
    s_cmp_lg_u32 s5, 4
    s_cbranch_scc1 L_end
    s_mov_b64 exec, s[50:51]
    global_load_dwordx4 v[96:99], v20, s[30:31] sc1
    s_mov_b64 exec, -1
    ds_read_b64 v[30:31], v29 offset:13824
    v_lshlrev_b32 v10, 16, v197
    v_and_b32 v11, 0xffff0000, v197
    s_mov_b32 s58, 40
    s_waitcnt lgkmcnt(0)
    v_add_f32_dpp v16, v30, v30 quad_perm:[1,0,3,2] row_mask:0xf bank_mask:0xf
    v_add_f32_dpp v18, v31, v31 quad_perm:[1,0,3,2] row_mask:0xf bank_mask:0xf
    s_nop 0
    v_add_f32_dpp v16, v16, v16 quad_perm:[2,3,0,1] row_mask:0xf bank_mask:0xf
    v_add_f32_dpp v18, v18, v18 quad_perm:[2,3,0,1] row_mask:0xf bank_mask:0xf
    s_nop 0
    v_add_f32_dpp v16, v16, v16 row_half_mirror row_mask:0xf bank_mask:0xf
    v_add_f32_dpp v18, v18, v18 row_half_mirror row_mask:0xf bank_mask:0xf
    s_nop 0
    v_add_f32_dpp v16, v16, v16 row_mirror row_mask:0xf bank_mask:0xf
    v_add_f32_dpp v18, v18, v18 row_mirror row_mask:0xf bank_mask:0xf
    s_mov_b64 exec, s[50:51]
    s_branch L_skipYA
L_pollYA:
    global_load_dwordx4 v[96:99], v20, s[30:31] sc1
L_skipYA:
    s_waitcnt vmcnt(0)
    v_cmp_eq_u32 vcc, s33, v97
    v_cmp_eq_u32 s[56:57], s34, v99
    s_and_b64 exec, vcc, s[56:57]
    v_mov_b32 v16, v96
    v_mov_b32 v18, v98
    s_andn2_b64 s[50:51], s[50:51], exec
    s_cbranch_scc0 L_doneY
    s_mov_b64 exec, s[50:51]
    s_sleep 1
    s_sub_u32 s58, s58, 1
    s_cbranch_scc0 L_pollYA
    s_mov_b32 s58, 262144
    s_mov_b64 exec, s[50:51]
L_pollY:
    global_load_dwordx4 v[96:99], v26, s[30:31] sc1
    s_waitcnt vmcnt(0)
    v_cmp_eq_u32 vcc, s33, v97
    v_cmp_eq_u32 s[56:57], s34, v99
    s_and_b64 exec, vcc, s[56:57]
    v_mov_b32 v16, v96
    v_mov_b32 v18, v98
    s_andn2_b64 s[50:51], s[50:51], exec
    s_cbranch_scc0 L_doneY
    s_mov_b64 exec, s[50:51]
    s_sleep 1
    s_sub_u32 s58, s58, 1
    s_cbranch_scc0 L_pollY
L_doneY:
    s_mov_b64 exec, -1
    v_permlane16_swap_b32 v16, v18
    v_add_f32 v16, v16, v18
    s_cmp_lg_u32 s2, 0
    s_nop 0
    v_add_f32_dpp v16, v16, v16 quad_perm:[1,0,3,2] row_mask:0xf bank_mask:0xf
    s_nop 1
    v_add_f32_dpp v16, v16, v16 quad_perm:[2,3,0,1] row_mask:0xf bank_mask:0xf
    s_nop 1
    v_add_f32_dpp v16, v16, v16 row_half_mirror row_mask:0xf bank_mask:0xf
    s_nop 1
    v_add_f32_dpp v16, v16, v16 row_mirror row_mask:0xf bank_mask:0xf
    s_nop 0
    v_readlane_b32 s56, v16, 16
    v_add_f32 v10, v10, v16
    s_mov_b64 exec, 1
    v_add_f32 v11, s56, v11
    v_cvt_pk_bf16_f32 v10, v10, v11
    global_store_dword v27, v10, s[26:27]
    s_cbranch_scc1 L_nowbump
    v_mov_b32 v12, 0
    global_store_dword v12, v13, s[30:31] sc1
L_nowbump:
L_end:
    s_endpgm
L_codeend:
.section .rodata,"a"
.p2align 6
.amdhsa_kernel parallel_sum__sliding_block_cached__geglu_ffn__decode_kernel
  .amdhsa_next_free_vgpr 256
  .amdhsa_next_free_sgpr 102
  .amdhsa_accum_offset 256
  .amdhsa_group_segment_fixed_size 0
  .amdhsa_kernarg_size 96
  .amdhsa_user_sgpr_count 2
  .amdhsa_user_sgpr_kernarg_segment_ptr 1
  .amdhsa_system_sgpr_workgroup_id_x 1
  .amdhsa_float_denorm_mode_32 3
.end_amdhsa_kernel
```
